```python
import torch

def _softmax(x, axis=-1):
    return torch.softmax(x, dim=axis)
def _gelu(x):
    return torch.nn.functional.gelu(x, approximate="tanh")
def _silu(x):
    return torch.nn.functional.silu(x)
def _sigmoid(x):
    return torch.sigmoid(x)
def _layernorm(x, axis=-1, eps=1e-5):
    m = x.mean(dim=axis, keepdim=True)
    v = x.var(dim=axis, keepdim=True, unbiased=False)
    return (x - m) / torch.sqrt(v + eps)
def _scatter_add(tgt, idx, src, axis=0):
    return tgt.clone().index_add_(axis, idx, src)
def _segment_sum(src, seg, n):
    out = torch.zeros((n,) + src.shape[1:], dtype=src.dtype)
    return out.index_add_(0, seg, src)
def _pad(x, pw):
    flat = tuple(v for pair in reversed(pw) for v in pair)
    return torch.nn.functional.pad(x, flat)

kernel_name = 'concat_heads__gqa_block_cached__mha_block_cached__decode'

def setup_inputs():

    _w = (lambda a: (lambda t: t.to(torch.bfloat16) if t.is_floating_point() else t)(torch.as_tensor(a)))
    def _A_setup():
        B, Sq, D = 8, 1, 448
        Hq, Hkv, Sk, Dh = 16, 8, 4096, 256
        assert Hq % Hkv == 0, (Hq, Hkv)
        return {
            "x": _w((lambda *s: torch.randn(*s, dtype=torch.bfloat16) * 0.8)(B, Sq, D)),
            "k_cache": _w((lambda *s: torch.randn(*s, dtype=torch.bfloat16) * 0.8)(B, Hkv, Sk, Dh)),
            "v_cache": _w((lambda *s: torch.randn(*s, dtype=torch.bfloat16) * 0.05)(B, Hkv, Sk, Dh)),
            "wq": _w((lambda *s: torch.randn(*s, dtype=torch.bfloat16) * 0.8)(D, Hq * Dh) * (D ** -0.5)),
            "wo": _w((lambda *s: torch.randn(*s, dtype=torch.bfloat16) * 0.05)(Hq * Dh, D) * ((Hq * Dh) ** -0.5)),
        }
    _A_in = _A_setup()

    def _B_setup():
        B, Sq, D = 8, 1, 448
        H, Sk, Dh = 16, 4096, 256
        return {
            "x": _w((lambda *s: torch.randn(*s, dtype=torch.bfloat16) * 0.8)(B, Sq, D)),
            "k_cache": _w((lambda *s: torch.randn(*s, dtype=torch.bfloat16) * 0.8)(B, H, Sk, Dh)),
            "v_cache": _w((lambda *s: torch.randn(*s, dtype=torch.bfloat16) * 0.05)(B, H, Sk, Dh)),
            "wq": _w((lambda *s: torch.randn(*s, dtype=torch.bfloat16) * 0.8)(D, H * Dh) * (D ** -0.5)),
            "wo": _w((lambda *s: torch.randn(*s, dtype=torch.bfloat16) * 0.05)(H * Dh, D) * ((H * Dh) ** -0.5)),
        }
    _B_in = _B_setup()

    return {
        "A_x": _A_in["x"],
        "A_k_cache": _A_in["k_cache"],
        "A_v_cache": _A_in["v_cache"],
        "A_wq": _A_in["wq"],
        "A_wo": _A_in["wo"],
        "B_x": _B_in["x"],
        "B_k_cache": _B_in["k_cache"],
        "B_v_cache": _B_in["v_cache"],
        "B_wq": _B_in["wq"],
        "B_wo": _B_in["wo"],
    }

def reference(A_x, A_k_cache, A_v_cache, A_wq, A_wo, B_x, B_k_cache, B_v_cache, B_wq, B_wo):
    def _A_ref(x, k_cache, v_cache, wq, wo):
        B, Sq, D = x.shape
        Hq, Dh = 16, 256
        Hkv = k_cache.shape[1]
        rep = Hq // Hkv
        q = (lambda x, *d: x.permute(*d))((x @ wq).reshape(B, Sq, Hq, Dh), 0, 2, 1, 3)
        k = (lambda x, n, axis: torch.repeat_interleave(x, n, dim=axis))(k_cache, rep, axis=1)
        v = (lambda x, n, axis: torch.repeat_interleave(x, n, dim=axis))(v_cache, rep, axis=1)
        scores = torch.einsum("bhqd,bhkd->bhqk", q, k) * (Dh ** -0.5)
        p = _softmax(scores, axis=-1)
        o = torch.einsum("bhqk,bhkd->bhqd", p, v)
        return (lambda x, *d: x.permute(*d))(o, 0, 2, 1, 3).reshape(B, Sq, Hq * Dh) @ wo

    def _B_ref(x, k_cache, v_cache, wq, wo):
        B, Sq, D = x.shape
        H, Dh = 16, 256
        q = (lambda x, *d: x.permute(*d))((x @ wq).reshape(B, Sq, H, Dh), 0, 2, 1, 3)
        scores = torch.einsum("bhqd,bhkd->bhqk", q, k_cache) * (Dh ** -0.5)
        p = _softmax(scores, axis=-1)
        o = torch.einsum("bhqk,bhkd->bhqd", p, v_cache)
        return (lambda x, *d: x.permute(*d))(o, 0, 2, 1, 3).reshape(B, Sq, H * Dh) @ wo

    a = _A_ref(A_x, A_k_cache, A_v_cache, A_wq, A_wo)
    b = _B_ref(B_x, B_k_cache, B_v_cache, B_wq, B_wo)
    return torch.concatenate([a, b], axis=-1)
```

```asm
; @launch grid=(256,1,1) block=(512,1,1) lds=157696
.amdgcn_target "amdgcn-amd-amdhsa--gfx950"
.text
.globl concat_heads__gqa_block_cached__mha_block_cached__decode_kernel
.p2align 8
.type concat_heads__gqa_block_cached__mha_block_cached__decode_kernel,@function
concat_heads__gqa_block_cached__mha_block_cached__decode_kernel:
  s_load_dwordx16 s[64:79], s[0:1], 0
  s_load_dwordx8 s[80:87], s[0:1], 64
  s_load_dwordx2 s[88:89], s[0:1], 96
  s_cmp_ge_u32 s2, 256
  s_cbranch_scc1 L_end
  v_lshrrev_b32 v1, 6, v0
  v_and_b32 v0, 63, v0
  s_mov_b32 s27, 0
  v_readfirstlane_b32 s3, v1
  s_cmp_eq_u32 s3, 0
  s_cbranch_scc1 L_w0
  s_sub_u32 s54, s3, 1
  v_and_b32 v2, 15, v0
  v_lshrrev_b32 v3, 4, v0
  s_and_b32 s13, s2, 3
  s_mul_i32 s13, s13, 112
  s_lshl_b32 s14, s54, 4
  s_add_u32 s13, s13, s14
  v_lshl_add_u32 v16, v3, 2, s13
  v_lshrrev_b32 v8, 2, v2
  v_mul_u32_u24 v8, 896, v8
  v_lshl_add_u32 v8, v16, 1, v8
  s_lshr_b32 s14, s2, 2
  s_and_b32 s14, s14, 31
  s_lshl_b32 s14, s14, 8
  v_lshlrev_b32 v9, 13, v16
  v_lshl_add_u32 v9, v2, 4, v9
  v_add_u32 v9, s14, v9
  s_mov_b32 s56, 8192
  s_mov_b32 s57, 16384
  s_mov_b32 s58, 24576
  v_mov_b32 v14, 155648
  v_mov_b32 v15, 1
  s_waitcnt lgkmcnt(0)
  s_cmp_ge_u32 s2, 128
  s_cselect_b32 s32, s80, s70
  s_cselect_b32 s33, s81, s71
  s_cselect_b32 s28, s74, s64
  s_cselect_b32 s29, s75, s65
  s_mov_b32 s34, 3670016
  s_mov_b32 s35, 0x20000
  s_mov_b32 s30, 7168
  s_mov_b32 s31, 0x20000
  buffer_load_dwordx4 v[40:43], v9, s[32:35], 0 offen nt
  buffer_load_dwordx4 v[44:47], v9, s[32:35], s56 offen nt
  buffer_load_dwordx4 v[48:51], v9, s[32:35], s57 offen nt
  buffer_load_dwordx4 v[52:55], v9, s[32:35], s58 offen nt
  buffer_load_dwordx2 v[10:11], v8, s[28:31], 0 offen offset:0
  buffer_load_dwordx2 v[12:13], v8, s[28:31], 0 offen offset:3584
  s_load_dword s26, s[88:89], 196612
  s_barrier
  s_mov_b64 s[20:21], s[86:87]
  s_mov_b64 s[22:23], s[88:89]
  s_mov_b64 s[24:25], s[84:85]
  s_mov_b64 s[36:37], s[72:73]
  s_mov_b64 s[38:39], s[82:83]
  v_and_b32 v16, 1, v2
  v_cmp_eq_u32 vcc, 1, v16
  v_mov_b32 v17, 0x0c0c0100
  v_mov_b32 v18, 0x01000c0c
  v_cndmask_b32 v17, v17, v18, vcc
  v_mov_b32 v18, 0x0c0c0302
  v_mov_b32 v19, 0x03020c0c
  v_cndmask_b32 v18, v18, v19, vcc
  v_bfe_u32 v16, v2, 1, 1
  v_mov_b32 v19, 0x0c0c0c0c
  v_cmp_eq_u32 vcc, 0, v16
  s_nop 1
  v_cndmask_b32 v4, v19, v17, vcc
  v_cndmask_b32 v6, v19, v18, vcc
  v_cmp_eq_u32 vcc, 1, v16
  s_nop 1
  v_cndmask_b32 v5, v19, v17, vcc
  v_cndmask_b32 v7, v19, v18, vcc
  s_lshl_b32 s13, s54, 12
  s_add_u32 s13, s13, 106496
  v_lshlrev_b32 v56, 9, v3
  v_lshl_add_u32 v56, v2, 5, v56
  v_add_u32 v56, s13, v56
  s_waitcnt vmcnt(0)
  v_perm_b32 v16, v10, v10, v4
  v_perm_b32 v17, v10, v10, v5
  v_perm_b32 v18, v12, v12, v4
  v_perm_b32 v19, v12, v12, v5
  s_nop 0
  v_mfma_f32_16x16x16_bf16 v[24:27], v[16:17], v[40:41], 0
  v_mfma_f32_16x16x16_bf16 v[28:31], v[16:17], v[42:43], 0
  v_mfma_f32_16x16x16_bf16 v[32:35], v[18:19], v[40:41], 0
  v_mfma_f32_16x16x16_bf16 v[36:39], v[18:19], v[42:43], 0
  v_perm_b32 v20, v10, v10, v6
  v_perm_b32 v21, v10, v10, v7
  v_perm_b32 v22, v12, v12, v6
  v_perm_b32 v23, v12, v12, v7
  s_nop 0
  v_mfma_f32_16x16x16_bf16 v[24:27], v[20:21], v[44:45], v[24:27]
  v_mfma_f32_16x16x16_bf16 v[28:31], v[20:21], v[46:47], v[28:31]
  v_mfma_f32_16x16x16_bf16 v[32:35], v[22:23], v[44:45], v[32:35]
  v_mfma_f32_16x16x16_bf16 v[36:39], v[22:23], v[46:47], v[36:39]
  v_perm_b32 v16, v11, v11, v4
  v_perm_b32 v17, v11, v11, v5
  v_perm_b32 v18, v13, v13, v4
  v_perm_b32 v19, v13, v13, v5
  s_nop 0
  v_mfma_f32_16x16x16_bf16 v[24:27], v[16:17], v[48:49], v[24:27]
  v_mfma_f32_16x16x16_bf16 v[28:31], v[16:17], v[50:51], v[28:31]
  v_mfma_f32_16x16x16_bf16 v[32:35], v[18:19], v[48:49], v[32:35]
  v_mfma_f32_16x16x16_bf16 v[36:39], v[18:19], v[50:51], v[36:39]
  v_perm_b32 v20, v11, v11, v6
  v_perm_b32 v21, v11, v11, v7
  v_perm_b32 v22, v13, v13, v6
  v_perm_b32 v23, v13, v13, v7
  s_nop 0
  v_mfma_f32_16x16x16_bf16 v[24:27], v[20:21], v[52:53], v[24:27]
  v_mfma_f32_16x16x16_bf16 v[28:31], v[20:21], v[54:55], v[28:31]
  v_mfma_f32_16x16x16_bf16 v[32:35], v[22:23], v[52:53], v[32:35]
  v_mfma_f32_16x16x16_bf16 v[36:39], v[22:23], v[54:55], v[36:39]
  s_nop 7
  s_nop 0
  ds_write_b128 v56, v[24:27] offset:0
  ds_write_b128 v56, v[28:31] offset:16
  ds_write_b128 v56, v[32:35] offset:2048
  ds_write_b128 v56, v[36:39] offset:2064
  s_waitcnt lgkmcnt(0)
  s_mov_b64 exec, 1
  ds_add_u32 v14, v15 offset:32
  s_mov_b64 exec, -1
  s_cmp_gt_u32 s3, 4
  s_cbranch_scc0 L_qred
  s_cmp_ge_u32 s2, 192
  s_cbranch_scc1 L_hout
  s_endpgm
L_qred:
  v_lshrrev_b32 v16, 5, v0
  v_and_b32 v17, 31, v0
  s_lshl_b32 s13, s54, 1
  v_add_u32 v16, s13, v16
  v_lshlrev_b32 v18, 9, v16
  v_lshl_add_u32 v18, v17, 4, v18
  v_add_u32 v18, 106496, v18
  s_lshl_b32 s13, s2, 13
  s_add_u32 s13, s13, 1048576
  v_lshlrev_b32 v19, 10, v16
  v_lshl_add_u32 v19, v17, 4, v19
  v_add_u32 v19, s13, v19
L_spin_1:
  ds_read_b32 v24, v14 offset:32
  s_waitcnt lgkmcnt(0)
  v_readfirstlane_b32 s13, v24
  s_cmp_ge_u32 s13, 7
  s_cbranch_scc1 L_spun_2
  s_add_u32 s27, s27, 1
  s_cmp_gt_u32 s27, 0x400000
  s_cbranch_scc1 L_end
  s_branch L_spin_1
L_spun_2:
  ds_read_b128 v[40:43], v18 offset:0
  ds_read_b128 v[44:47], v18 offset:4096
  ds_read_b128 v[48:51], v18 offset:8192
  ds_read_b128 v[52:55], v18 offset:12288
  ds_read_b128 v[56:59], v18 offset:16384
  ds_read_b128 v[60:63], v18 offset:20480
  ds_read_b128 v[64:67], v18 offset:24576
  s_add_u32 s26, s26, 0x9e3779b1
  s_lshl_b32 s13, s54, 2
  s_add_u32 s13, s13, 155664
  v_mov_b32 v20, s13
  s_waitcnt lgkmcnt(0)
  ds_write_b32 v20, v15
  v_add_f32 v40, v40, v44
  v_add_f32 v48, v48, v52
  v_add_f32 v56, v56, v60
  v_add_f32 v41, v41, v45
  v_add_f32 v49, v49, v53
  v_add_f32 v57, v57, v61
  v_add_f32 v42, v42, v46
  v_add_f32 v50, v50, v54
  v_add_f32 v58, v58, v62
  v_add_f32 v43, v43, v47
  v_add_f32 v51, v51, v55
  v_add_f32 v59, v59, v63
  v_add_f32 v40, v40, v48
  v_add_f32 v56, v56, v64
  v_add_f32 v41, v41, v49
  v_add_f32 v57, v57, v65
  v_add_f32 v42, v42, v50
  v_add_f32 v58, v58, v66
  v_add_f32 v43, v43, v51
  v_add_f32 v59, v59, v67
  v_add_f32 v68, v40, v56
  v_mov_b32 v69, s26
  v_add_f32 v70, v41, v57
  v_mov_b32 v71, s26
  v_add_f32 v72, v42, v58
  v_mov_b32 v73, s26
  v_add_f32 v74, v43, v59
  v_mov_b32 v75, s26
  global_store_dwordx4 v19, v[68:71], s[22:23] sc1
  global_store_dwordx4 v19, v[72:75], s[22:23] offset:512 sc1
  s_cmp_ge_u32 s2, 192
  s_cbranch_scc1 L_hout
  s_and_b32 s4, s2, 7
  s_lshr_b32 s5, s2, 3
  s_and_b32 s6, s5, 7
  s_lshr_b32 s7, s5, 3
  s_cmp_lg_u32 s7, 0
  s_cselect_b32 s12, 1, 0
  s_lshr_b32 s14, s7, 1
  s_lshl_b32 s14, s14, 3
  s_add_u32 s11, s4, s14
  s_add_u32 s14, s12, 3
  s_lshl_b32 s10, s6, s14
  s_add_u32 s10, s10, s11
  v_and_b32 v16, 7, v2
  v_lshrrev_b32 v17, 1, v16
  v_and_b32 v16, 1, v16
  v_cmp_eq_u32 vcc, 1, v16
  v_mov_b32 v18, 0x0c0c0100
  v_mov_b32 v19, 0x01000c0c
  v_cndmask_b32 v18, v18, v19, vcc
  v_mov_b32 v19, 0x0c0c0302
  v_mov_b32 v20, 0x03020c0c
  v_cndmask_b32 v19, v19, v20, vcc
  v_mov_b32 v20, 0x0c0c0c0c
  v_cmp_eq_u32 vcc, 0, v17
  s_nop 1
  v_cndmask_b32 v4, v20, v18, vcc
  v_cndmask_b32 v8, v20, v19, vcc
  v_cmp_eq_u32 vcc, 1, v17
  s_nop 1
  v_cndmask_b32 v5, v20, v18, vcc
  v_cndmask_b32 v9, v20, v19, vcc
  v_cmp_eq_u32 vcc, 2, v17
  s_nop 1
  v_cndmask_b32 v6, v20, v18, vcc
  v_cndmask_b32 v10, v20, v19, vcc
  v_cmp_eq_u32 vcc, 3, v17
  s_nop 1
  v_cndmask_b32 v7, v20, v18, vcc
  v_cndmask_b32 v11, v20, v19, vcc
  s_cmp_eq_u32 s12, 1
  s_cbranch_scc0 L_qg
  s_cmp_ge_u32 s54, 2
  s_cbranch_scc1 L_qg_done
L_qg:
  s_sub_u32 s14, 2, s12
  s_lshl_b32 s13, s11, s14
  s_add_u32 s13, s13, s54
  s_lshl_b32 s14, s12, 5
  s_add_u32 s13, s13, s14
  s_lshl_b32 s13, s13, 15
  s_lshl_b32 s14, s6, 10
  s_add_u32 s13, s13, s14
  s_add_u32 s13, s13, 1048576
  v_lshlrev_b32 v16, 4, v0
  v_add_u32 v16, s13, v16
  v_add_u32 v17, 8192, v16
  v_add_u32 v18, 16384, v16
  v_add_u32 v19, 24576, v16
  global_load_dwordx4 v[160:163], v16, s[22:23] sc1
  global_load_dwordx4 v[164:167], v17, s[22:23] sc1
  global_load_dwordx4 v[168:171], v18, s[22:23] sc1
  global_load_dwordx4 v[172:175], v19, s[22:23] sc1
  s_sleep 16
L_qg_poll:
  global_load_dwordx4 v[176:179], v16, s[22:23] sc1
  global_load_dwordx4 v[180:183], v17, s[22:23] sc1
  global_load_dwordx4 v[184:187], v18, s[22:23] sc1
  global_load_dwordx4 v[188:191], v19, s[22:23] sc1
  s_waitcnt vmcnt(4)
  v_xor_b32 v20, s26, v161
  v_xor_b32 v21, s26, v163
  v_or_b32 v20, v20, v21
  v_xor_b32 v21, s26, v165
  v_or_b32 v20, v20, v21
  v_xor_b32 v21, s26, v167
  v_or_b32 v20, v20, v21
  v_xor_b32 v21, s26, v169
  v_or_b32 v20, v20, v21
  v_xor_b32 v21, s26, v171
  v_or_b32 v20, v20, v21
  v_xor_b32 v21, s26, v173
  v_or_b32 v20, v20, v21
  v_xor_b32 v21, s26, v175
  v_or_b32 v20, v20, v21
  v_cmp_eq_u32 vcc, 0, v20
  s_nop 1
  s_cmp_eq_u64 vcc, -1
  s_cbranch_scc1 L_qg_gotA
  global_load_dwordx4 v[160:163], v16, s[22:23] sc1
  global_load_dwordx4 v[164:167], v17, s[22:23] sc1
  global_load_dwordx4 v[168:171], v18, s[22:23] sc1
  global_load_dwordx4 v[172:175], v19, s[22:23] sc1
  s_waitcnt vmcnt(4)
  v_xor_b32 v20, s26, v177
  v_xor_b32 v21, s26, v179
  v_or_b32 v20, v20, v21
  v_xor_b32 v21, s26, v181
  v_or_b32 v20, v20, v21
  v_xor_b32 v21, s26, v183
  v_or_b32 v20, v20, v21
  v_xor_b32 v21, s26, v185
  v_or_b32 v20, v20, v21
  v_xor_b32 v21, s26, v187
  v_or_b32 v20, v20, v21
  v_xor_b32 v21, s26, v189
  v_or_b32 v20, v20, v21
  v_xor_b32 v21, s26, v191
  v_or_b32 v20, v20, v21
  v_cmp_eq_u32 vcc, 0, v20
  s_nop 1
  s_cmp_eq_u64 vcc, -1
  s_cbranch_scc1 L_qg_gotB
  s_add_u32 s27, s27, 1
  s_cmp_gt_u32 s27, 0x400000
  s_cbranch_scc1 L_end
  s_branch L_qg_poll
L_qg_gotB:
  v_add_f32 v32, v176, v180
  v_add_f32 v34, v178, v182
  v_add_f32 v40, v184, v188
  v_add_f32 v42, v186, v190
  s_branch L_qg_got
L_qg_gotA:
  v_add_f32 v32, v160, v164
  v_add_f32 v34, v162, v166
  v_add_f32 v40, v168, v172
  v_add_f32 v42, v170, v174
L_qg_got:
  v_add_f32 v32, v32, v40
  v_add_f32 v34, v34, v42
  v_cvt_pk_bf16_f32 v32, v32, v34
  v_and_b32 v20, 31, v0
  v_lshrrev_b32 v21, 5, v0
  v_lshlrev_b32 v20, 3, v20
  v_lshl_add_u32 v20, v21, 2, v20
  s_lshl_b32 s13, s54, 8
  s_add_u32 s13, s13, 155904
  v_add_u32 v20, s13, v20
  ds_write_b32 v20, v32
L_qg_done:
  s_waitcnt lgkmcnt(0)
  s_mov_b64 exec, 1
  ds_add_u32 v14, v15 offset:36
  s_mov_b64 exec, -1
  v_lshrrev_b32 v112, 3, v2
  v_and_b32 v26, 12, v2
  v_xor_b32 v26, 0, v26
  v_and_b32 v27, 3, v2
  v_xor_b32 v27, v27, v3
  v_add_u32 v26, v26, v27
  v_lshlrev_b32 v26, 4, v26
  v_lshl_add_u32 v64, v2, 9, v26
  v_and_b32 v26, 12, v2
  v_xor_b32 v26, 4, v26
  v_and_b32 v27, 3, v2
  v_xor_b32 v27, v27, v3
  v_add_u32 v26, v26, v27
  v_lshlrev_b32 v26, 4, v26
  v_lshl_add_u32 v65, v2, 9, v26
  v_and_b32 v26, 12, v2
  v_xor_b32 v26, 8, v26
  v_and_b32 v27, 3, v2
  v_xor_b32 v27, v27, v3
  v_add_u32 v26, v26, v27
  v_lshlrev_b32 v26, 4, v26
  v_lshl_add_u32 v66, v2, 9, v26
  v_and_b32 v26, 12, v2
  v_xor_b32 v26, 12, v26
  v_and_b32 v27, 3, v2
  v_xor_b32 v27, v27, v3
  v_add_u32 v26, v26, v27
  v_lshlrev_b32 v26, 4, v26
  v_lshl_add_u32 v67, v2, 9, v26
  s_lshl_b32 s13, s54, 12
  s_add_u32 s13, s13, 139264
  v_lshlrev_b32 v109, 5, v112
  v_lshl_add_u32 v109, v3, 3, v109
  v_add_u32 v109, s13, v109
  v_mov_b32 v108, 0xff800000
  s_lshl_b32 s13, s54, 2
  s_add_u32 s13, s13, 155664
  v_mov_b32 v110, s13
  s_mov_b32 s48, s54
  s_mov_b32 s49, 0
  s_lshl_b32 s50, s54, 13
  s_mov_b32 s51, 2
  s_mov_b32 s52, 0x01010101
  s_mov_b32 s53, 0x01010101
  s_cmp_eq_u32 s12, 1
  s_cselect_b32 s13, 0, 512
  v_mul_lo_u32 v26, v112, s13
  v_lshl_add_u32 v26, v3, 4, v26
  v_add_u32 v26, 155904, v26
L_spin_3:
  ds_read_b32 v24, v14 offset:36
  s_waitcnt lgkmcnt(0)
  v_readfirstlane_b32 s13, v24
  s_cmp_ge_u32 s13, 4
  s_cbranch_scc1 L_spun_4
  s_add_u32 s27, s27, 1
  s_cmp_gt_u32 s27, 0x400000
  s_cbranch_scc1 L_end
  s_branch L_spin_3
L_spun_4:
  ds_read_b128 v[32:35], v26 offset:0
  ds_read_b128 v[36:39], v26 offset:64
  ds_read_b128 v[40:43], v26 offset:128
  ds_read_b128 v[44:47], v26 offset:192
  ds_read_b128 v[48:51], v26 offset:256
  ds_read_b128 v[52:55], v26 offset:320
  ds_read_b128 v[56:59], v26 offset:384
  ds_read_b128 v[60:63], v26 offset:448
  s_waitcnt lgkmcnt(0)
L_K:
  v_add_u32 v68, s50, v64
  v_add_u32 v69, s50, v65
  v_add_u32 v70, s50, v66
  v_add_u32 v71, s50, v67
  v_mov_b32 v111, s51
  s_cmp_gt_i32 s49, s48
  s_cbranch_scc1 L_K_go
L_K_spin:
  ds_read_b32 v24, v14 offset:0
  s_waitcnt lgkmcnt(0)
  v_readfirstlane_b32 s49, v24
  s_cmp_gt_i32 s49, s48
  s_cbranch_scc1 L_K_go
  s_add_u32 s27, s27, 1
  s_cmp_gt_u32 s27, 0x400000
  s_cbranch_scc1 L_end
  s_cmp_ge_u32 s48, 500
  s_cbranch_scc1 L_K_spin
  s_sleep 24
  s_branch L_K_spin
L_K_go:
  ds_read_b128 v[72:75], v68 offset:0
  ds_read_b128 v[76:79], v69 offset:0
  ds_read_b128 v[80:83], v70 offset:0
  ds_read_b128 v[84:87], v71 offset:0
  ds_read_b128 v[88:91], v68 offset:256
  ds_read_b128 v[92:95], v69 offset:256
  ds_read_b128 v[96:99], v70 offset:256
  ds_read_b128 v[100:103], v71 offset:256
  s_waitcnt lgkmcnt(7)
  v_mfma_f32_16x16x32_bf16 v[104:107], v[72:75], v[32:35], 0
  s_waitcnt lgkmcnt(6)
  v_mfma_f32_16x16x32_bf16 v[104:107], v[76:79], v[36:39], v[104:107]
  s_waitcnt lgkmcnt(5)
  v_mfma_f32_16x16x32_bf16 v[104:107], v[80:83], v[40:43], v[104:107]
  s_waitcnt lgkmcnt(4)
  v_mfma_f32_16x16x32_bf16 v[104:107], v[84:87], v[44:47], v[104:107]
  s_waitcnt lgkmcnt(3)
  v_mfma_f32_16x16x32_bf16 v[104:107], v[88:91], v[48:51], v[104:107]
  s_waitcnt lgkmcnt(2)
  v_mfma_f32_16x16x32_bf16 v[104:107], v[92:95], v[52:55], v[104:107]
  s_waitcnt lgkmcnt(1)
  v_mfma_f32_16x16x32_bf16 v[104:107], v[96:99], v[56:59], v[104:107]
  s_waitcnt lgkmcnt(0)
  ds_write_b32 v110, v111
  v_mfma_f32_16x16x32_bf16 v[104:107], v[100:103], v[60:63], v[104:107]
  s_add_u32 s48, s48, 4
  s_add_u32 s50, s50, 32768
  s_cmp_ge_u32 s50, 139264
  s_cselect_b32 s13, 139264, 0
  s_sub_u32 s50, s50, s13
  s_add_u32 s51, s51, 1
  s_nop 3
  v_max3_f32 v108, v108, v104, v105
  v_max3_f32 v108, v108, v106, v107
  v_cvt_pk_bf16_f32 v104, v104, v105
  v_cvt_pk_bf16_f32 v105, v106, v107
  s_mov_b64 exec, s[52:53]
  ds_write_b64 v109, v[104:105]
  s_mov_b64 exec, -1
  v_add_u32 v109, 64, v109
  s_cmp_lt_u32 s48, 256
  s_cbranch_scc1 L_K
  s_lshl_b32 s13, s54, 4
  s_add_u32 s13, s13, 156928
  v_lshlrev_b32 v26, 6, v112
  v_lshl_add_u32 v27, v3, 2, v26
  v_add_u32 v27, s13, v27
  s_mov_b64 exec, s[52:53]
  ds_write_b32 v27, v108
  s_mov_b64 exec, -1
  s_waitcnt lgkmcnt(0)
  s_mov_b64 exec, 1
  ds_add_u32 v14, v15 offset:40
  s_mov_b64 exec, -1
L_spin_5:
  ds_read_b32 v24, v14 offset:40
  s_waitcnt lgkmcnt(0)
  v_readfirstlane_b32 s13, v24
  s_cmp_ge_u32 s13, 4
  s_cbranch_scc1 L_spun_6
  s_add_u32 s27, s27, 1
  s_cmp_gt_u32 s27, 0x400000
  s_cbranch_scc1 L_end
  s_branch L_spin_5
L_spun_6:
  v_add_u32 v26, 156928, v26
  ds_read_b128 v[72:75], v26 offset:0
  ds_read_b128 v[76:79], v26 offset:16
  ds_read_b128 v[80:83], v26 offset:32
  ds_read_b128 v[84:87], v26 offset:48
  v_subrev_u32 v109, 4096, v109
  s_waitcnt lgkmcnt(0)
  v_max3_f32 v72, v72, v73, v74
  v_max3_f32 v72, v72, v75, v76
  v_max3_f32 v72, v72, v77, v78
  v_max3_f32 v72, v72, v79, v80
  v_max3_f32 v72, v72, v81, v82
  v_max3_f32 v72, v72, v83, v84
  v_max3_f32 v72, v72, v85, v86
  v_max_f32 v72, v72, v87
  v_cvt_pk_bf16_f32 v72, v72, v72
  v_and_b32 v72, 0xffff0000, v72
  s_mov_b32 s55, 0x3db8aa3b
  v_mul_f32 v113, s55, v72
  v_sub_f32 v113, 0, v113
  v_mov_b32 v114, 0
  v_lshlrev_b32 v115, 11, v3
  v_lshl_add_u32 v115, v2, 4, v115
  v_mov_b32 v120, 0
  v_mov_b32 v121, 0
  v_mov_b32 v122, 0
  v_mov_b32 v123, 0
  v_mov_b32 v124, 0
  v_mov_b32 v125, 0
  v_mov_b32 v126, 0
  v_mov_b32 v127, 0
  s_cmp_eq_u32 s54, 0
  s_cselect_b32 s56, 480, 0
  v_mov_b32 v117, 64
L_V:
  ds_read_b64 v[118:119], v109
  v_add_u32 v116, s50, v115
  v_add_u32 v109, 64, v109
  v_mov_b32 v111, s51
  s_waitcnt lgkmcnt(0)
  v_lshlrev_b32 v104, 16, v118
  v_and_b32 v105, 0xffff0000, v118
  v_lshlrev_b32 v106, 16, v119
  v_and_b32 v107, 0xffff0000, v119
  v_fma_f32 v104, v104, s55, v113
  v_fma_f32 v105, v105, s55, v113
  v_fma_f32 v106, v106, s55, v113
  v_fma_f32 v107, v107, s55, v113
  v_exp_f32 v104, v104
  v_exp_f32 v105, v105
  v_exp_f32 v106, v106
  v_exp_f32 v107, v107
  s_nop 0
  v_cvt_pk_bf16_f32 v118, v104, v105
  v_cvt_pk_bf16_f32 v119, v106, v107
  v_add_f32 v104, v104, v105
  v_add_f32 v106, v106, v107
  v_add_f32 v114, v114, v104
  v_add_f32 v114, v114, v106
  v_perm_b32 v128, v118, v118, v4
  v_perm_b32 v129, v118, v118, v5
  v_perm_b32 v130, v118, v118, v6
  v_perm_b32 v131, v118, v118, v7
  v_perm_b32 v132, v118, v118, v8
  v_perm_b32 v133, v118, v118, v9
  v_perm_b32 v134, v118, v118, v10
  v_perm_b32 v135, v118, v118, v11
  v_perm_b32 v136, v119, v119, v4
  v_perm_b32 v137, v119, v119, v5
  v_perm_b32 v138, v119, v119, v6
  v_perm_b32 v139, v119, v119, v7
  v_perm_b32 v140, v119, v119, v8
  v_perm_b32 v141, v119, v119, v9
  v_perm_b32 v142, v119, v119, v10
  v_perm_b32 v143, v119, v119, v11
  s_cmp_gt_i32 s49, s48
  s_cbranch_scc1 L_V_go
L_V_spin:
  ds_read_b32 v24, v14 offset:0
  s_waitcnt lgkmcnt(0)
  v_readfirstlane_b32 s49, v24
  s_cmp_gt_i32 s49, s48
  s_cbranch_scc1 L_V_go
  s_add_u32 s27, s27, 1
  s_cmp_gt_u32 s27, 0x400000
  s_cbranch_scc1 L_end
  s_cmp_ge_u32 s48, 500
  s_cbranch_scc1 L_V_spin
  s_sleep 24
  s_branch L_V_spin
L_V_go:
  ds_read_b128 v[72:75], v116 offset:0
  ds_read_b128 v[76:79], v116 offset:256
  ds_read_b128 v[80:83], v116 offset:512
  ds_read_b128 v[84:87], v116 offset:768
  ds_read_b128 v[88:91], v116 offset:1024
  ds_read_b128 v[92:95], v116 offset:1280
  ds_read_b128 v[96:99], v116 offset:1536
  ds_read_b128 v[100:103], v116 offset:1792
  s_waitcnt lgkmcnt(7)
  v_mfma_f32_16x16x32_bf16 v[120:123], v[128:131], v[72:75], v[120:123]
  s_waitcnt lgkmcnt(6)
  v_mfma_f32_16x16x32_bf16 v[124:127], v[128:131], v[76:79], v[124:127]
  s_waitcnt lgkmcnt(5)
  v_mfma_f32_16x16x32_bf16 v[120:123], v[132:135], v[80:83], v[120:123]
  s_waitcnt lgkmcnt(4)
  v_mfma_f32_16x16x32_bf16 v[124:127], v[132:135], v[84:87], v[124:127]
  s_waitcnt lgkmcnt(3)
  v_mfma_f32_16x16x32_bf16 v[120:123], v[136:139], v[88:91], v[120:123]
  s_waitcnt lgkmcnt(2)
  v_mfma_f32_16x16x32_bf16 v[124:127], v[136:139], v[92:95], v[124:127]
  s_waitcnt lgkmcnt(1)
  v_mfma_f32_16x16x32_bf16 v[120:123], v[140:143], v[96:99], v[120:123]
  s_waitcnt lgkmcnt(0)
  ds_write_b32 v110, v111
  v_mfma_f32_16x16x32_bf16 v[124:127], v[140:143], v[100:103], v[124:127]
  s_add_u32 s48, s48, 4
  s_add_u32 s50, s50, 32768
  s_cmp_ge_u32 s50, 139264
  s_cselect_b32 s13, 139264, 0
  s_sub_u32 s50, s50, s13
  s_add_u32 s51, s51, 1
  s_cmp_lg_u32 s56, s48
  s_cbranch_scc1 L_notrig
  s_mov_b64 exec, 1
  global_atomic_add v117, v15, s[20:21] sc1
  s_mov_b64 exec, -1
L_notrig:
  s_cmp_lt_u32 s48, 512
  s_cbranch_scc1 L_V
  s_lshl_b32 s13, s54, 12
  s_add_u32 s13, s13, 139264
  v_lshrrev_b32 v26, 1, v3
  v_lshlrev_b32 v26, 10, v26
  v_and_b32 v27, 1, v3
  v_lshl_add_u32 v26, v27, 4, v26
  v_lshl_add_u32 v26, v2, 5, v26
  v_add_u32 v26, s13, v26
  s_lshl_b32 s13, s54, 4
  s_add_u32 s13, s13, 157056
  v_lshlrev_b32 v27, 6, v112
  v_lshl_add_u32 v27, v3, 2, v27
  v_add_u32 v27, s13, v27
  s_nop 1
  ds_write_b128 v26, v[120:123]
  ds_write_b128 v26, v[124:127] offset:512
  s_mov_b64 exec, s[52:53]
  ds_write_b32 v27, v114
  s_mov_b64 exec, -1
  s_waitcnt lgkmcnt(0)
  s_mov_b64 exec, 1
  ds_add_rtn_u32 v24, v14, v15 offset:44
  s_mov_b64 exec, -1
  v_lshrrev_b32 v25, 5, v0
  v_and_b32 v28, 31, v0
  v_lshlrev_b32 v26, 10, v25
  v_lshl_add_u32 v26, v28, 5, v26
  v_add_u32 v26, 139264, v26
  v_lshlrev_b32 v27, 6, v25
  v_add_u32 v27, 157056, v27
  s_lshl_b32 s13, s12, 16
  s_lshl_b32 s14, s6, 13
  s_add_u32 s13, s13, s14
  s_sub_u32 s14, 10, s12
  s_lshl_b32 s14, s11, s14
  s_add_u32 s13, s13, s14
  s_add_u32 s13, s13, 0
  v_lshlrev_b32 v29, 4, v0
  v_add_u32 v29, s13, v29
  s_waitcnt lgkmcnt(0)
  v_readfirstlane_b32 s13, v24
  s_cmp_eq_u32 s13, 3
  s_cbranch_scc0 L_end
  ds_read_b128 v[32:35], v26 offset:0
  ds_read_b128 v[36:39], v26 offset:16
  ds_read_b128 v[40:43], v26 offset:4096
  ds_read_b128 v[44:47], v26 offset:4112
  ds_read_b128 v[48:51], v26 offset:8192
  ds_read_b128 v[52:55], v26 offset:8208
  ds_read_b128 v[56:59], v26 offset:12288
  ds_read_b128 v[60:63], v26 offset:12304
  ds_read_b128 v[64:67], v27 offset:0
  ds_read_b128 v[68:71], v27 offset:16
  ds_read_b128 v[72:75], v27 offset:32
  ds_read_b128 v[76:79], v27 offset:48
  s_lshl_b32 s13, s12, 7
  s_lshl_b32 s14, s11, 2
  s_add_u32 s13, s13, s14
  v_mov_b32 v30, s13
  s_waitcnt lgkmcnt(0)
  v_add_f32 v64, v64, v72
  v_add_f32 v65, v65, v73
  v_add_f32 v66, v66, v74
  v_add_f32 v67, v67, v75
  v_add_f32 v68, v68, v76
  v_add_f32 v69, v69, v77
  v_add_f32 v70, v70, v78
  v_add_f32 v71, v71, v79
  v_add_f32 v64, v64, v68
  v_add_f32 v65, v65, v69
  v_add_f32 v66, v66, v70
  v_add_f32 v67, v67, v71
  v_add_f32 v64, v64, v65
  v_add_f32 v66, v66, v67
  v_add_f32 v64, v64, v66
  v_rcp_f32 v64, v64
  v_add_f32 v32, v32, v40
  v_add_f32 v48, v48, v56
  v_add_f32 v33, v33, v41
  v_add_f32 v49, v49, v57
  v_add_f32 v34, v34, v42
  v_add_f32 v50, v50, v58
  v_add_f32 v35, v35, v43
  v_add_f32 v51, v51, v59
  v_add_f32 v36, v36, v44
  v_add_f32 v52, v52, v60
  v_add_f32 v37, v37, v45
  v_add_f32 v53, v53, v61
  v_add_f32 v38, v38, v46
  v_add_f32 v54, v54, v62
  v_add_f32 v39, v39, v47
  v_add_f32 v55, v55, v63
  v_add_f32 v32, v32, v48
  v_add_f32 v33, v33, v49
  v_add_f32 v34, v34, v50
  v_add_f32 v35, v35, v51
  v_add_f32 v36, v36, v52
  v_add_f32 v37, v37, v53
  v_add_f32 v38, v38, v54
  v_add_f32 v39, v39, v55
  v_mul_f32 v32, v32, v64
  v_mul_f32 v33, v33, v64
  v_mul_f32 v34, v34, v64
  v_mul_f32 v35, v35, v64
  v_mul_f32 v36, v36, v64
  v_mul_f32 v37, v37, v64
  v_mul_f32 v38, v38, v64
  v_mul_f32 v39, v39, v64
  v_cvt_pk_bf16_f32 v32, v32, v33
  v_cvt_pk_bf16_f32 v33, v34, v35
  v_cvt_pk_bf16_f32 v34, v36, v37
  v_cvt_pk_bf16_f32 v35, v38, v39
  s_cmp_eq_u32 s12, 1
  s_cselect_b32 exec_hi, 0, -1
  global_store_dwordx4 v29, v[32:35], s[22:23] sc1
  s_waitcnt vmcnt(0)
  s_mov_b64 exec, 1
  global_atomic_add v30, v15, s[20:21] sc1
  s_endpgm
L_w0:
  s_cmp_ge_u32 s2, 192
  s_cbranch_scc1 L_h0
  s_setprio 3
  s_and_b32 s4, s2, 7
  s_lshr_b32 s5, s2, 3
  s_and_b32 s6, s5, 7
  s_lshr_b32 s7, s5, 3
  s_cmp_lg_u32 s7, 0
  s_cselect_b32 s12, 1, 0
  s_lshr_b32 s14, s7, 1
  s_lshl_b32 s14, s14, 3
  s_add_u32 s11, s4, s14
  s_add_u32 s14, s12, 3
  s_lshl_b32 s10, s6, s14
  s_add_u32 s10, s10, s11
  v_mov_b32 v2, 0
  v_lshlrev_b32 v3, 2, v0
  v_add_u32 v3, 155648, v3
  ds_write_b32 v3, v2
  v_mov_b32 v4, 155648
  v_lshrrev_b32 v6, 5, v0
  v_and_b32 v7, 31, v0
  v_add_u32 v8, 0, v6
  v_xor_b32 v8, v8, v7
  v_lshlrev_b32 v8, 4, v8
  v_lshl_add_u32 v8, v6, 9, v8
  v_add_u32 v9, 2, v6
  v_xor_b32 v9, v9, v7
  v_lshlrev_b32 v9, 4, v9
  v_lshl_add_u32 v9, v6, 9, v9
  v_add_u32 v10, 4, v6
  v_xor_b32 v10, v10, v7
  v_lshlrev_b32 v10, 4, v10
  v_lshl_add_u32 v10, v6, 9, v10
  v_add_u32 v11, 6, v6
  v_xor_b32 v11, v11, v7
  v_lshlrev_b32 v11, 4, v11
  v_lshl_add_u32 v11, v6, 9, v11
  v_add_u32 v12, 8, v6
  v_xor_b32 v12, v12, v7
  v_lshlrev_b32 v12, 4, v12
  v_lshl_add_u32 v12, v6, 9, v12
  v_add_u32 v12, 4096, v12
  v_add_u32 v13, 10, v6
  v_xor_b32 v13, v13, v7
  v_lshlrev_b32 v13, 4, v13
  v_lshl_add_u32 v13, v6, 9, v13
  v_add_u32 v13, 4096, v13
  v_add_u32 v14, 12, v6
  v_xor_b32 v14, v14, v7
  v_lshlrev_b32 v14, 4, v14
  v_lshl_add_u32 v14, v6, 9, v14
  v_add_u32 v14, 4096, v14
  v_add_u32 v15, 14, v6
  v_xor_b32 v15, v15, v7
  v_lshlrev_b32 v15, 4, v15
  v_lshl_add_u32 v15, v6, 9, v15
  v_add_u32 v15, 4096, v15
  v_lshlrev_b32 v16, 4, v0
  v_add_u32 v17, 4096, v16
  s_lshl_b32 s13, s10, 21
  s_waitcnt lgkmcnt(0)
  s_cmp_ge_u32 s2, 64
  s_cselect_b32 s16, s76, s66
  s_cselect_b32 s17, s77, s67
  s_cselect_b32 s18, s78, s68
  s_cselect_b32 s19, s79, s69
  s_barrier
  s_add_u32 s28, s16, s13
  s_addc_u32 s29, s17, 0
  s_mov_b32 s30, 0x200000
  s_mov_b32 s31, 0x20000
  s_add_u32 s32, s18, s13
  s_addc_u32 s33, s19, 0
  s_mov_b32 s34, 0x200000
  s_mov_b32 s35, 0x20000
  s_mov_b32 s48, 0
  s_mov_b32 s49, 13
  s_mov_b32 s50, 0
  s_mov_b32 s52, -4
  s_mov_b32 s51, 0
L_ld_tile0:
  s_cmp_lt_u32 s48, s49
  s_cbranch_scc1 L_ld_go0
L_ld_ref0:
  ds_read_b128 v[20:23], v4 offset:16
  s_waitcnt lgkmcnt(0)
  v_min_u32 v20, v20, v21
  v_min3_u32 v20, v20, v22, v23
  s_nop 0
  v_readfirstlane_b32 s49, v20
  s_lshl_b32 s49, s49, 2
  s_add_u32 s49, s49, 13
  s_cmp_lt_u32 s48, s49
  s_cbranch_scc1 L_ld_go0
  s_add_u32 s27, s27, 1
  s_cmp_gt_u32 s27, 0x400000
  s_cbranch_scc1 L_end
  s_sleep 1
  s_branch L_ld_ref0
L_ld_go0:
  s_mov_b32 m0, s50
  s_waitcnt vmcnt(36)
  buffer_load_dwordx4 v8, s[28:31], s51 offen offset:0 nt lds
  buffer_load_dwordx4 v9, s[28:31], s51 offen offset:1024 nt lds
  buffer_load_dwordx4 v10, s[28:31], s51 offen offset:2048 nt lds
  buffer_load_dwordx4 v11, s[28:31], s51 offen offset:3072 nt lds
  s_add_u32 m0, s50, 4096
  v_mov_b32 v5, s52
  s_waitcnt vmcnt(36)
  ds_write_b32 v4, v5 offset:0
  buffer_load_dwordx4 v12, s[28:31], s51 offen offset:0 nt lds
  buffer_load_dwordx4 v13, s[28:31], s51 offen offset:1024 nt lds
  buffer_load_dwordx4 v14, s[28:31], s51 offen offset:2048 nt lds
  buffer_load_dwordx4 v15, s[28:31], s51 offen offset:3072 nt lds
  s_add_u32 s51, s51, 8192
  s_add_u32 s50, s50, 8192
  s_cmp_eq_u32 s50, 139264
  s_cselect_b32 s50, 0, s50
  s_add_u32 s52, s52, 1
  s_add_u32 s48, s48, 1
  s_cmp_lt_u32 s48, 256
  s_cbranch_scc1 L_ld_tile0
  s_mov_b32 s51, 0
L_ld_tile1:
  s_cmp_lt_u32 s48, s49
  s_cbranch_scc1 L_ld_go1
L_ld_ref1:
  ds_read_b128 v[20:23], v4 offset:16
  s_waitcnt lgkmcnt(0)
  v_min_u32 v20, v20, v21
  v_min3_u32 v20, v20, v22, v23
  s_nop 0
  v_readfirstlane_b32 s49, v20
  s_lshl_b32 s49, s49, 2
  s_add_u32 s49, s49, 13
  s_cmp_lt_u32 s48, s49
  s_cbranch_scc1 L_ld_go1
  s_add_u32 s27, s27, 1
  s_cmp_gt_u32 s27, 0x400000
  s_cbranch_scc1 L_end
  s_sleep 1
  s_branch L_ld_ref1
L_ld_go1:
  s_mov_b32 m0, s50
  s_waitcnt vmcnt(36)
  buffer_load_dwordx4 v16, s[32:35], s51 offen offset:0 nt lds
  buffer_load_dwordx4 v16, s[32:35], s51 offen offset:1024 nt lds
  buffer_load_dwordx4 v16, s[32:35], s51 offen offset:2048 nt lds
  buffer_load_dwordx4 v16, s[32:35], s51 offen offset:3072 nt lds
  s_add_u32 m0, s50, 4096
  v_mov_b32 v5, s52
  s_waitcnt vmcnt(36)
  ds_write_b32 v4, v5 offset:0
  buffer_load_dwordx4 v17, s[32:35], s51 offen offset:0 nt lds
  buffer_load_dwordx4 v17, s[32:35], s51 offen offset:1024 nt lds
  buffer_load_dwordx4 v17, s[32:35], s51 offen offset:2048 nt lds
  buffer_load_dwordx4 v17, s[32:35], s51 offen offset:3072 nt lds
  s_add_u32 s51, s51, 8192
  s_add_u32 s50, s50, 8192
  s_cmp_eq_u32 s50, 139264
  s_cselect_b32 s50, 0, s50
  s_add_u32 s52, s52, 1
  s_add_u32 s48, s48, 1
  s_cmp_lt_u32 s48, 512
  s_cbranch_scc1 L_ld_tile1
  v_mov_b32 v5, 508
  s_waitcnt vmcnt(32)
  ds_write_b32 v4, v5 offset:0
  v_mov_b32 v5, 509
  s_waitcnt vmcnt(24)
  ds_write_b32 v4, v5 offset:0
  v_mov_b32 v5, 510
  s_waitcnt vmcnt(16)
  ds_write_b32 v4, v5 offset:0
  v_mov_b32 v5, 511
  s_waitcnt vmcnt(8)
  ds_write_b32 v4, v5 offset:0
  v_mov_b32 v5, 512
  s_waitcnt vmcnt(0)
  ds_write_b32 v4, v5 offset:0
  s_endpgm
L_h0:
  v_mov_b32 v2, 0
  v_lshlrev_b32 v3, 2, v0
  v_add_u32 v3, 155648, v3
  ds_write_b32 v3, v2
  s_waitcnt lgkmcnt(0)
  s_mov_b64 s[20:21], s[86:87]
  s_mov_b64 s[22:23], s[88:89]
  s_mov_b64 s[24:25], s[84:85]
  s_mov_b64 s[36:37], s[72:73]
  s_mov_b64 s[38:39], s[82:83]
  s_barrier
L_hout:
  s_sub_u32 s54, s2, 192
  s_and_b32 s4, s54, 7
  s_lshr_b32 s14, s54, 3
  s_and_b32 s5, s14, 3
  s_lshr_b32 s14, s54, 5
  s_lshl_b32 s14, s14, 3
  s_add_u32 s7, s14, s4
  s_cmp_ge_u32 s7, 14
  s_cbranch_scc1 L_h_idle
  s_cmp_ge_u32 s7, 7
  s_cselect_b32 s12, 1, 0
  s_cselect_b32 s14, 7, 0
  s_cselect_b32 s16, s38, s36
  s_cselect_b32 s17, s39, s37
  s_sub_u32 s7, s7, s14
  s_lshl_b32 s11, s7, 2
  s_add_u32 s11, s11, s5
  v_and_b32 v2, 15, v0
  v_lshrrev_b32 v3, 4, v0
  s_mul_i32 s13, s3, 458752
  s_lshl_b32 s14, s11, 5
  s_add_u32 s13, s13, s14
  v_lshrrev_b32 v4, 1, v0
  v_mul_u32_u24 v4, 896, v4
  v_and_b32 v5, 1, v0
  v_lshl_add_u32 v4, v5, 4, v4
  v_add_u32 v4, s13, v4
  s_lshl_b32 s55, s3, 14
  v_and_b32 v5, 3, v0
  v_bfe_u32 v6, v0, 2, 2
  v_lshlrev_b32 v5, 3, v5
  v_lshl_add_u32 v5, v6, 5, v5
  v_lshl_add_u32 v5, v3, 8, v5
  v_add_u32 v5, s55, v5
  s_lshl_b32 s13, s3, 10
  v_lshlrev_b32 v6, 4, v0
  v_add_u32 v9, s55, v6
  v_add_u32 v6, s13, v6
  s_mov_b32 s58, 0
  s_mov_b32 s59, 8192
  s_mov_b32 s60, 16384
  s_mov_b32 s61, 24576
  s_mov_b32 s62, 32768
  s_mov_b32 s63, 40960
  s_mov_b32 s64, 49152
  s_mov_b32 s65, 57344
  v_and_b32 v10, 7, v2
  v_mul_u32_u24 v10, 1056, v10
  v_lshl_add_u32 v10, v3, 4, v10
  v_add_u32 v10, s55, v10
  s_lshl_b32 s13, s12, 3
  s_add_u32 s13, s13, 7
  v_and_b32 v7, s13, v0
  v_lshlrev_b32 v7, 2, v7
  s_lshl_b32 s13, s12, 7
  v_add_u32 v7, s13, v7
  s_mov_b32 s28, s16
  s_mov_b32 s29, s17
  s_mov_b32 s30, 3670016
  s_mov_b32 s31, 0x20000
  s_lshl_b32 s13, s12, 16
  s_add_u32 s13, s13, 0
  s_add_u32 s32, s22, s13
  s_addc_u32 s33, s23, 0
  s_mov_b32 s34, 65536
  s_mov_b32 s35, 0x20000
  s_cmp_lg_u32 s3, 0
  s_cbranch_scc1 L_h_w1
  v_mov_b32 v11, 64
L_h_poll1:
  global_load_dword v8, v11, s[20:21] sc1
  s_waitcnt vmcnt(0)
  v_cmp_lt_u32 vcc, 0, v8
  s_nop 1
  s_cmp_lg_u64 vcc, 0
  s_cbranch_scc1 L_h_w1
  s_add_u32 s27, s27, 1
  s_cmp_gt_u32 s27, 0x400000
  s_cbranch_scc1 L_end
  s_sleep 16
  s_branch L_h_poll1
L_h_w1:
  s_barrier
  s_add_u32 m0, s55, 0
  s_mov_b32 s13, 0
  buffer_load_dwordx4 v4, s[28:31], s13 offen nt lds
  s_add_u32 m0, s55, 1024
  s_mov_b32 s13, 28672
  buffer_load_dwordx4 v4, s[28:31], s13 offen nt lds
  s_add_u32 m0, s55, 2048
  s_mov_b32 s13, 57344
  buffer_load_dwordx4 v4, s[28:31], s13 offen nt lds
  s_add_u32 m0, s55, 3072
  s_mov_b32 s13, 86016
  buffer_load_dwordx4 v4, s[28:31], s13 offen nt lds
  s_add_u32 m0, s55, 4096
  s_mov_b32 s13, 114688
  buffer_load_dwordx4 v4, s[28:31], s13 offen nt lds
  s_add_u32 m0, s55, 5120
  s_mov_b32 s13, 143360
  buffer_load_dwordx4 v4, s[28:31], s13 offen nt lds
  s_add_u32 m0, s55, 6144
  s_mov_b32 s13, 172032
  buffer_load_dwordx4 v4, s[28:31], s13 offen nt lds
  s_add_u32 m0, s55, 7168
  s_mov_b32 s13, 200704
  buffer_load_dwordx4 v4, s[28:31], s13 offen nt lds
  s_add_u32 m0, s55, 8192
  s_mov_b32 s13, 229376
  buffer_load_dwordx4 v4, s[28:31], s13 offen nt lds
  s_add_u32 m0, s55, 9216
  s_mov_b32 s13, 258048
  buffer_load_dwordx4 v4, s[28:31], s13 offen nt lds
  s_add_u32 m0, s55, 10240
  s_mov_b32 s13, 286720
  buffer_load_dwordx4 v4, s[28:31], s13 offen nt lds
  s_add_u32 m0, s55, 11264
  s_mov_b32 s13, 315392
  buffer_load_dwordx4 v4, s[28:31], s13 offen nt lds
  s_add_u32 m0, s55, 12288
  s_mov_b32 s13, 344064
  buffer_load_dwordx4 v4, s[28:31], s13 offen nt lds
  s_add_u32 m0, s55, 13312
  s_mov_b32 s13, 372736
  buffer_load_dwordx4 v4, s[28:31], s13 offen nt lds
  s_add_u32 m0, s55, 14336
  s_mov_b32 s13, 401408
  buffer_load_dwordx4 v4, s[28:31], s13 offen nt lds
  s_add_u32 m0, s55, 15360
  s_mov_b32 s13, 430080
  buffer_load_dwordx4 v4, s[28:31], s13 offen nt lds
  s_waitcnt vmcnt(15)
  ds_read_b64_tr_b16 v[64:65], v5 offset:0
  ds_read_b64_tr_b16 v[66:67], v5 offset:128
  s_waitcnt vmcnt(14)
  ds_read_b64_tr_b16 v[68:69], v5 offset:1024
  ds_read_b64_tr_b16 v[70:71], v5 offset:1152
  s_waitcnt vmcnt(13)
  ds_read_b64_tr_b16 v[72:73], v5 offset:2048
  ds_read_b64_tr_b16 v[74:75], v5 offset:2176
  s_waitcnt vmcnt(12)
  ds_read_b64_tr_b16 v[76:77], v5 offset:3072
  ds_read_b64_tr_b16 v[78:79], v5 offset:3200
  s_waitcnt vmcnt(11)
  ds_read_b64_tr_b16 v[80:81], v5 offset:4096
  ds_read_b64_tr_b16 v[82:83], v5 offset:4224
  s_waitcnt vmcnt(10)
  ds_read_b64_tr_b16 v[84:85], v5 offset:5120
  ds_read_b64_tr_b16 v[86:87], v5 offset:5248
  s_waitcnt vmcnt(9)
  ds_read_b64_tr_b16 v[88:89], v5 offset:6144
  ds_read_b64_tr_b16 v[90:91], v5 offset:6272
  s_waitcnt vmcnt(8)
  ds_read_b64_tr_b16 v[92:93], v5 offset:7168
  ds_read_b64_tr_b16 v[94:95], v5 offset:7296
  s_waitcnt vmcnt(7)
  ds_read_b64_tr_b16 v[96:97], v5 offset:8192
  ds_read_b64_tr_b16 v[98:99], v5 offset:8320
  s_waitcnt vmcnt(6)
  ds_read_b64_tr_b16 v[100:101], v5 offset:9216
  ds_read_b64_tr_b16 v[102:103], v5 offset:9344
  s_waitcnt vmcnt(5)
  ds_read_b64_tr_b16 v[104:105], v5 offset:10240
  ds_read_b64_tr_b16 v[106:107], v5 offset:10368
  s_waitcnt vmcnt(4)
  ds_read_b64_tr_b16 v[108:109], v5 offset:11264
  ds_read_b64_tr_b16 v[110:111], v5 offset:11392
  s_waitcnt vmcnt(3)
  ds_read_b64_tr_b16 v[112:113], v5 offset:12288
  ds_read_b64_tr_b16 v[114:115], v5 offset:12416
  s_waitcnt vmcnt(2)
  ds_read_b64_tr_b16 v[116:117], v5 offset:13312
  ds_read_b64_tr_b16 v[118:119], v5 offset:13440
  s_waitcnt vmcnt(1)
  ds_read_b64_tr_b16 v[120:121], v5 offset:14336
  ds_read_b64_tr_b16 v[122:123], v5 offset:14464
  s_waitcnt vmcnt(0)
  ds_read_b64_tr_b16 v[124:125], v5 offset:15360
  ds_read_b64_tr_b16 v[126:127], v5 offset:15488
  s_waitcnt lgkmcnt(0)
  v_mov_b32 v14, 155648
  s_cmp_lg_u32 s3, 0
  s_cbranch_scc1 L_h_wait
L_h_poll:
  global_load_dword v8, v7, s[20:21] sc1
  s_waitcnt vmcnt(0)
  v_cmp_le_u32 vcc, 8, v8
  s_nop 1
  v_mov_b32 v15, vcc_lo
  ds_write_b32 v14, v15 offset:48
  s_cmp_eq_u64 vcc, -1
  s_cbranch_scc1 L_h_go
  s_add_u32 s27, s27, 1
  s_cmp_gt_u32 s27, 0x400000
  s_cbranch_scc1 L_end
  s_bcnt1_i32_b64 s56, vcc
  s_cmp_ge_u32 s56, 48
  s_cbranch_scc1 L_h_fast
  s_sleep 16
  s_branch L_h_poll
L_h_fast:
  global_load_dword v8, v7, s[20:21] sc1
  s_sleep 10
L_h_fast2:
  global_load_dword v240, v7, s[20:21] sc1
  s_waitcnt vmcnt(1)
  v_cmp_le_u32 vcc, 8, v8
  s_nop 1
  v_mov_b32 v15, vcc_lo
  ds_write_b32 v14, v15 offset:48
  s_cmp_eq_u64 vcc, -1
  s_cbranch_scc1 L_h_go
  global_load_dword v8, v7, s[20:21] sc1
  s_waitcnt vmcnt(1)
  v_cmp_le_u32 vcc, 8, v240
  s_nop 1
  v_mov_b32 v15, vcc_lo
  ds_write_b32 v14, v15 offset:48
  s_cmp_eq_u64 vcc, -1
  s_cbranch_scc1 L_h_go
  s_add_u32 s27, s27, 1
  s_cmp_gt_u32 s27, 0x400000
  s_cbranch_scc1 L_end
  s_branch L_h_fast2
L_h_wait:
  s_lshl_b32 s56, s3, s12
  s_lshl_b32 s57, s12, 1
  s_add_u32 s57, s57, 1
  s_lshl_b32 s57, s57, s56
L_h_rdy:
  ds_read_b32 v15, v14 offset:48
  s_waitcnt lgkmcnt(0)
  v_readfirstlane_b32 s56, v15
  s_and_b32 s56, s56, s57
  s_cmp_eq_u32 s56, s57
  s_cbranch_scc1 L_h_go
  s_add_u32 s27, s27, 1
  s_cmp_gt_u32 s27, 0x400000
  s_cbranch_scc1 L_end
  s_sleep 2
  s_branch L_h_rdy
L_h_go:
  buffer_load_dwordx4 v[128:131], v6, s[32:35], s58 offen sc1
  buffer_load_dwordx4 v[132:135], v6, s[32:35], s59 offen sc1
  buffer_load_dwordx4 v[136:139], v6, s[32:35], s60 offen sc1
  buffer_load_dwordx4 v[140:143], v6, s[32:35], s61 offen sc1
  buffer_load_dwordx4 v[144:147], v6, s[32:35], s62 offen sc1
  buffer_load_dwordx4 v[148:151], v6, s[32:35], s63 offen sc1
  buffer_load_dwordx4 v[152:155], v6, s[32:35], s64 offen sc1
  buffer_load_dwordx4 v[156:159], v6, s[32:35], s65 offen sc1
  s_waitcnt vmcnt(7)
  ds_write_b128 v9, v[128:131] offset:0
  s_waitcnt vmcnt(6)
  ds_write_b128 v9, v[132:135] offset:1056
  s_waitcnt vmcnt(5)
  ds_write_b128 v9, v[136:139] offset:2112
  s_waitcnt vmcnt(4)
  ds_write_b128 v9, v[140:143] offset:3168
  s_waitcnt vmcnt(3)
  ds_write_b128 v9, v[144:147] offset:4224
  s_waitcnt vmcnt(2)
  ds_write_b128 v9, v[148:151] offset:5280
  s_waitcnt vmcnt(1)
  ds_write_b128 v9, v[152:155] offset:6336
  s_waitcnt vmcnt(0)
  ds_write_b128 v9, v[156:159] offset:7392
  s_waitcnt lgkmcnt(0)
  ds_read_b128 v[160:163], v10 offset:0
  ds_read_b128 v[164:167], v10 offset:64
  ds_read_b128 v[168:171], v10 offset:128
  ds_read_b128 v[172:175], v10 offset:192
  ds_read_b128 v[176:179], v10 offset:256
  ds_read_b128 v[180:183], v10 offset:320
  ds_read_b128 v[184:187], v10 offset:384
  ds_read_b128 v[188:191], v10 offset:448
  ds_read_b128 v[192:195], v10 offset:512
  ds_read_b128 v[196:199], v10 offset:576
  ds_read_b128 v[200:203], v10 offset:640
  ds_read_b128 v[204:207], v10 offset:704
  ds_read_b128 v[208:211], v10 offset:768
  ds_read_b128 v[212:215], v10 offset:832
  ds_read_b128 v[216:219], v10 offset:896
  ds_read_b128 v[220:223], v10 offset:960
  s_lshl_b32 s13, s3, 9
  s_add_u32 s13, s13, 131072
  v_lshlrev_b32 v11, 8, v3
  v_lshl_add_u32 v11, v2, 2, v11
  v_add_u32 v11, s13, v11
  s_waitcnt lgkmcnt(15)
  v_mfma_f32_16x16x32_bf16 v[12:15], v[160:163], v[64:67], 0
  s_waitcnt lgkmcnt(14)
  v_mfma_f32_16x16x32_bf16 v[16:19], v[164:167], v[68:71], 0
  s_waitcnt lgkmcnt(13)
  v_mfma_f32_16x16x32_bf16 v[12:15], v[168:171], v[72:75], v[12:15]
  s_waitcnt lgkmcnt(12)
  v_mfma_f32_16x16x32_bf16 v[16:19], v[172:175], v[76:79], v[16:19]
  s_waitcnt lgkmcnt(11)
  v_mfma_f32_16x16x32_bf16 v[12:15], v[176:179], v[80:83], v[12:15]
  s_waitcnt lgkmcnt(10)
  v_mfma_f32_16x16x32_bf16 v[16:19], v[180:183], v[84:87], v[16:19]
  s_waitcnt lgkmcnt(9)
  v_mfma_f32_16x16x32_bf16 v[12:15], v[184:187], v[88:91], v[12:15]
  s_waitcnt lgkmcnt(8)
  v_mfma_f32_16x16x32_bf16 v[16:19], v[188:191], v[92:95], v[16:19]
  s_waitcnt lgkmcnt(7)
  v_mfma_f32_16x16x32_bf16 v[12:15], v[192:195], v[96:99], v[12:15]
  s_waitcnt lgkmcnt(6)
  v_mfma_f32_16x16x32_bf16 v[16:19], v[196:199], v[100:103], v[16:19]
  s_waitcnt lgkmcnt(5)
  v_mfma_f32_16x16x32_bf16 v[12:15], v[200:203], v[104:107], v[12:15]
  s_waitcnt lgkmcnt(4)
  v_mfma_f32_16x16x32_bf16 v[16:19], v[204:207], v[108:111], v[16:19]
  s_waitcnt lgkmcnt(3)
  v_mfma_f32_16x16x32_bf16 v[12:15], v[208:211], v[112:115], v[12:15]
  s_waitcnt lgkmcnt(2)
  v_mfma_f32_16x16x32_bf16 v[16:19], v[212:215], v[116:119], v[16:19]
  s_waitcnt lgkmcnt(1)
  v_mfma_f32_16x16x32_bf16 v[12:15], v[216:219], v[120:123], v[12:15]
  s_waitcnt lgkmcnt(0)
  v_mfma_f32_16x16x32_bf16 v[16:19], v[220:223], v[124:127], v[16:19]
  s_nop 7
  v_add_f32 v12, v12, v16
  v_add_f32 v13, v13, v17
  v_add_f32 v14, v14, v18
  v_add_f32 v15, v15, v19
  s_mov_b32 exec_hi, 0
  ds_write_b32 v11, v12 offset:0
  ds_write_b32 v11, v13 offset:64
  ds_write_b32 v11, v14 offset:128
  ds_write_b32 v11, v15 offset:192
  s_mov_b64 exec, -1
  v_lshrrev_b32 v20, 3, v0
  v_and_b32 v21, 7, v0
  v_lshlrev_b32 v22, 6, v20
  v_lshl_add_u32 v22, v21, 3, v22
  v_add_u32 v22, 131072, v22
  s_mul_i32 s13, s12, 896
  s_lshl_b32 s14, s11, 5
  s_add_u32 s13, s13, s14
  v_mul_u32_u24 v23, 1792, v20
  v_lshl_add_u32 v23, v21, 2, v23
  v_add_u32 v23, s13, v23
  s_mov_b32 s28, s24
  s_mov_b32 s29, s25
  s_mov_b32 s30, 14336
  s_mov_b32 s31, 0x20000
  s_waitcnt lgkmcnt(0)
  s_barrier
  s_cmp_lg_u32 s3, 0
  s_cbranch_scc1 L_end
  ds_read_b64 v[24:25], v22 offset:0
  ds_read_b64 v[26:27], v22 offset:512
  ds_read_b64 v[28:29], v22 offset:1024
  ds_read_b64 v[30:31], v22 offset:1536
  ds_read_b64 v[32:33], v22 offset:2048
  ds_read_b64 v[34:35], v22 offset:2560
  ds_read_b64 v[36:37], v22 offset:3072
  ds_read_b64 v[38:39], v22 offset:3584
  s_waitcnt lgkmcnt(0)
  v_add_f32 v24, v24, v26
  v_add_f32 v25, v25, v27
  v_add_f32 v28, v28, v30
  v_add_f32 v29, v29, v31
  v_add_f32 v32, v32, v34
  v_add_f32 v33, v33, v35
  v_add_f32 v36, v36, v38
  v_add_f32 v37, v37, v39
  v_add_f32 v24, v24, v28
  v_add_f32 v25, v25, v29
  v_add_f32 v32, v32, v36
  v_add_f32 v33, v33, v37
  v_add_f32 v24, v24, v32
  v_add_f32 v25, v25, v33
  v_cvt_pk_bf16_f32 v24, v24, v25
  buffer_store_dword v24, v23, s[28:31], 0 offen
  s_endpgm
L_h_idle:
  s_cmp_lg_u32 s2, 230
  s_cbranch_scc1 L_end
  s_cmp_lg_u32 s3, 0
  s_cbranch_scc1 L_end
  s_load_dword s26, s[22:23], 196612
  v_cmp_gt_u32 vcc, 8, v0
  v_lshlrev_b32 v4, 2, v0
  v_add_u32 v5, 96, v4
  v_cndmask_b32 v4, v5, v4, vcc
  v_cmp_gt_u32 vcc, 24, v0
  v_mov_b32 v5, 0
  s_nop 0
  v_cndmask_b32 v4, v5, v4, vcc
  s_waitcnt lgkmcnt(0)
  s_add_u32 s26, s26, 0x9e3779b1
L_e_poll:
  global_load_dword v8, v4, s[20:21] sc1
  s_waitcnt vmcnt(0)
  v_cmp_le_u32 vcc, 8, v8
  s_nop 1
  s_cmp_eq_u64 vcc, -1
  s_cbranch_scc1 L_e_done
  s_add_u32 s27, s27, 1
  s_cmp_gt_u32 s27, 0x400000
  s_cbranch_scc1 L_end
  v_cmp_lt_u32 vcc, 0, v8
  s_nop 1
  s_cmp_lg_u64 vcc, 0
  s_cbranch_scc1 L_e_fast
  s_sleep 32
L_e_fast:
  s_sleep 4
  s_branch L_e_poll
L_e_done:
  v_mov_b32 v4, 196612
  v_mov_b32 v5, s26
  s_mov_b64 exec, 1
  global_store_dword v4, v5, s[22:23]
L_end:
  s_endpgm
.section .rodata,"a"
.p2align 6
.amdhsa_kernel concat_heads__gqa_block_cached__mha_block_cached__decode_kernel
  .amdhsa_next_free_vgpr 256
  .amdhsa_next_free_sgpr 96
  .amdhsa_accum_offset 256
  .amdhsa_group_segment_fixed_size 0
  .amdhsa_kernarg_size 104
  .amdhsa_user_sgpr_count 2
  .amdhsa_user_sgpr_kernarg_segment_ptr 1
  .amdhsa_system_sgpr_workgroup_id_x 1
.end_amdhsa_kernel
```
